```python
import torch

def _softmax(x, axis=-1):
    return torch.softmax(x, dim=axis)
def _gelu(x):
    return torch.nn.functional.gelu(x, approximate="tanh")
def _silu(x):
    return torch.nn.functional.silu(x)
def _sigmoid(x):
    return torch.sigmoid(x)
def _layernorm(x, axis=-1, eps=1e-5):
    m = x.mean(dim=axis, keepdim=True)
    v = x.var(dim=axis, keepdim=True, unbiased=False)
    return (x - m) / torch.sqrt(v + eps)
def _scatter_add(tgt, idx, src, axis=0):
    return tgt.clone().index_add_(axis, idx, src)
def _segment_sum(src, seg, n):
    out = torch.zeros((n,) + src.shape[1:], dtype=src.dtype)
    return out.index_add_(0, seg, src)
def _pad(x, pw):
    flat = tuple(v for pair in reversed(pw) for v in pair)
    return torch.nn.functional.pad(x, flat)

kernel_name = 'standalone__glu_gated_geglu__sampling'

def setup_inputs():

    _w = (lambda a: (lambda t: t.to(torch.bfloat16) if t.is_floating_point() else t)(torch.as_tensor(a)))
    B, S, Dm, Df = 8, 4, 1024, 3584
    return {
        "x": _w((lambda *s: torch.randn(*s, dtype=torch.bfloat16) * 0.05)(B, S, Dm)),
        "w_gate": _w((lambda *s: torch.randn(*s, dtype=torch.bfloat16) * 0.05)(Dm, Df) * (Dm ** -0.5)),
        "w_up": _w((lambda *s: torch.randn(*s, dtype=torch.bfloat16) * 0.05)(Dm, Df) * (Dm ** -0.5)),
        "w_down": _w((lambda *s: torch.randn(*s, dtype=torch.bfloat16) * 0.05)(Df, Dm) * (Df ** -0.5)),
    }

def reference(x, w_gate, w_up, w_down):
    g = torch.einsum("bsd,df->bsf", x, w_gate)
    u = torch.einsum("bsd,df->bsf", x, w_up)
    h = _gelu(g) * u
    return torch.einsum("bsf,fd->bsd", h, w_down)
```

```asm
; @launch grid=(256,1,1) block=(512,1,1) lds=141312
.amdgcn_target "amdgcn-amd-amdhsa--gfx950"
.text
.globl standalone__glu_gated_geglu__sampling_kernel
.p2align 8
.type standalone__glu_gated_geglu__sampling_kernel,@function
standalone__glu_gated_geglu__sampling_kernel:
    s_cmp_ge_u32 s2, 256
    s_cbranch_scc1 L_exit0
    s_load_dwordx8 s[4:11], s[0:1], 0
    s_load_dwordx4 s[12:15], s[0:1], 32
    s_load_dwordx2 s[16:17], s[0:1], 48
    s_memrealtime s[18:19]
    v_and_b32 v1, 63, v0
    v_lshrrev_b32 v10, 6, v0
    s_and_b32 s44, s2, 7
    s_lshr_b32 s45, s2, 3
    v_readfirstlane_b32 s46, v10
    s_cmp_lt_u32 s45, 24
    s_cselect_b32 s53, 4, 8
    s_cmp_ge_u32 s46, s53
    s_cbranch_scc0 L_cont
    s_sub_u32 s53, s45, 1
    s_cmp_ge_u32 s53, 2
    s_cbranch_scc1 L_exit1
    s_getpc_b64 s[70:71]
L_pcref2:
    s_sub_u32 s70, s70, L_pcref2-standalone__glu_gated_geglu__sampling_kernel
    s_subb_u32 s71, s71, 0
    v_subrev_u32 v10, 256, v0
    v_lshlrev_b32 v10, 6, v10
    v_min_u32 v10, L_codeend-standalone__glu_gated_geglu__sampling_kernel-4, v10
    global_load_dword v11, v10, s[70:71]
L_exit1:
L_exit0:
    s_endpgm
L_leader:
    s_cmp_lg_u32 s46, 0
    s_cbranch_scc1 L_leader_bar
    s_mul_i32 s53, s18, 0x9E3779B1
    s_lshr_b32 s56, s53, 15
    s_xor_b32 s53, s53, s56
    s_mul_i32 s53, s53, 0x85EBCA77
    s_lshr_b32 s56, s53, 13
    s_xor_b32 s53, s53, s56
    s_max_u32 s53, s53, 1
    v_mov_b32 v10, s53
    s_mov_b64 exec, 1
    buffer_store_dword v10, v8, s[36:39], 0 offen sc1
    s_mov_b64 exec, -1
L_leader_bar:
    s_barrier
    s_branch L_noleader
L_cont:
    s_lshr_b32 s82, s46, 2
    s_and_b32 s46, s46, 3
    s_add_u32 s49, s44, 3
    s_and_b32 s49, s49, 7
    s_min_u32 s49, s49, 6
    s_lshr_b32 s53, s45, 2
    s_cmp_ge_u32 s53, s49
    s_addc_u32 s53, s53, 0
    s_and_b32 s48, s45, 3
    s_sub_u32 s54, s45, 24
    s_cmp_ge_u32 s45, 24
    s_cselect_b32 s53, s49, s53
    s_cselect_b32 s48, s54, s48
    s_cselect_b32 s55, 8, 9
    s_mul_i32 s47, s44, 7
    s_add_u32 s47, s47, s53
    s_lshr_b32 s54, s48, 1
    s_lshl_b32 s54, s54, s55
    s_mul_i32 s57, s54, 7168
    s_lshl_b32 s53, s47, 7
    s_add_u32 s57, s57, s53
    s_lshl_b32 s58, s54, 1
    v_lshrrev_b32 v33, 3, v0
    v_and_b32 v10, 7, v0
    v_bfe_u32 v11, v0, 4, 2
    v_lshlrev_b32 v32, 1, v11
    v_xor_b32 v32, v32, v10
    v_lshlrev_b32 v32, 4, v32
    v_lshl_add_u32 v3, v33, 11, v32
    v_and_b32 v32, 1, v11
    v_lshlrev_b32 v32, 1, v32
    v_bfe_u32 v11, v0, 6, 1
    v_lshl_or_b32 v32, v11, 2, v32
    v_xor_b32 v32, v32, v10
    v_lshlrev_b32 v32, 4, v32
    v_mul_u32_u24 v2, 7168, v33
    v_add_u32 v2, v2, v32
    s_lshl_b32 s68, s46, 10
    s_lshl_b32 s69, s46, 13
    v_mov_b32 v8, 0
    s_mov_b32 s26, 7340032
    s_mov_b32 s27, 0x20000
    s_mov_b32 s22, 65536
    s_mov_b32 s23, 0x20000
    s_mov_b32 s38, 256
    s_mov_b32 s39, 0x20000
    s_bitcmp0_b32 s48, 0
    s_waitcnt lgkmcnt(0)
    s_cselect_b32 s24, s6, s8
    s_cselect_b32 s25, s7, s9
    s_mov_b64 s[20:21], s[4:5]
    s_mov_b64 s[36:37], s[14:15]
    s_cmp_eq_u32 s2, 0
    s_cbranch_scc1 L_leader
L_noleader:
    s_cmp_lg_u32 s82, 0
    s_cbranch_scc1 L_skipfirst
    s_add_u32 m0, s68, 0
    s_add_u32 s53, s57, 0
    buffer_load_dwordx4 v2, s[24:27], s53 offen nt lds
    s_add_u32 m0, s69, 65536
    s_add_u32 s53, s58, 0
    buffer_load_dwordx4 v3, s[20:23], s53 offen lds
    s_add_u32 m0, s68, 4096
    s_add_u32 s53, s57, 229376
    buffer_load_dwordx4 v2, s[24:27], s53 offen nt lds
    s_add_u32 m0, s69, 66560
    s_add_u32 s53, s58, 128
    buffer_load_dwordx4 v3, s[20:23], s53 offen lds
    s_add_u32 m0, s68, 8192
    s_add_u32 s53, s57, 458752
    buffer_load_dwordx4 v2, s[24:27], s53 offen nt lds
    s_add_u32 m0, s68, 12288
    s_add_u32 s53, s57, 688128
    buffer_load_dwordx4 v2, s[24:27], s53 offen nt lds
    s_add_u32 m0, s69, 67584
    s_add_u32 s53, s58, 256
    buffer_load_dwordx4 v3, s[20:23], s53 offen lds
    s_add_u32 m0, s68, 16384
    s_add_u32 s53, s57, 917504
    buffer_load_dwordx4 v2, s[24:27], s53 offen nt lds
    s_add_u32 m0, s68, 20480
    s_add_u32 s53, s57, 1146880
    buffer_load_dwordx4 v2, s[24:27], s53 offen nt lds
    s_add_u32 m0, s69, 68608
    s_add_u32 s53, s58, 384
    buffer_load_dwordx4 v3, s[20:23], s53 offen lds
    s_add_u32 m0, s68, 24576
    s_add_u32 s53, s57, 1376256
    buffer_load_dwordx4 v2, s[24:27], s53 offen nt lds
    s_add_u32 m0, s68, 28672
    s_add_u32 s53, s57, 1605632
    buffer_load_dwordx4 v2, s[24:27], s53 offen nt lds
L_skipfirst:
    s_mov_b64 s[28:29], s[10:11]
    s_mov_b64 s[40:41], s[16:17]
    s_mov_b64 s[32:33], s[12:13]
    s_mov_b32 s30, 7340032
    s_mov_b32 s31, 0x20000
    s_mov_b32 s42, 17825792
    s_mov_b32 s43, 0x20000
    s_mov_b32 s34, 65536
    s_mov_b32 s35, 0x20000
    s_mul_i32 s53, s45, 43
    s_lshr_b32 s53, s53, 7
    s_add_u32 s53, s53, s45
    s_lshl_b32 s54, s48, 2
    s_add_u32 s54, s54, 3
    s_cmp_ge_u32 s45, 24
    s_cselect_b32 s53, s54, s53
    s_and_b32 s51, s53, 15
    s_lshr_b32 s53, s53, 4
    s_lshl_b32 s50, s44, 1
    s_add_u32 s50, s50, s53
    s_mul_i32 s59, s50, 458752
    s_lshl_b32 s53, s51, 7
    s_add_u32 s59, s59, s53
    v_lshlrev_b32 v9, 4, v1
    v_lshrrev_b32 v11, 4, v1
    v_bfe_u32 v10, v1, 2, 2
    v_and_b32 v32, 3, v1
    v_and_b32 v7, 1, v11
    v_lshlrev_b32 v7, 1, v7
    v_lshrrev_b32 v4, 1, v10
    v_or_b32 v7, v7, v4
    v_xor_b32 v7, s46, v7
    v_lshlrev_b32 v7, 5, v7
    v_lshl_add_u32 v7, v32, 3, v7
    v_lshl_add_u32 v7, v10, 7, v7
    v_lshl_add_u32 v4, v11, 10, v7
    v_lshl_add_u32 v7, v11, 9, v7
    v_add_u32 v7, 98304, v7
    s_mov_b32 s60, 0x07060500
    s_mov_b32 s61, 0x07060501
    s_mov_b32 s62, 0x07060502
    s_mov_b32 s63, 0x07060503
    s_mov_b32 s13, 0x0c0c0400
    s_mov_b32 s14, 0x04000c0c
    s_mov_b32 s15, 0
    s_mov_b32 s66, 0
    s_mov_b32 s16, 0
    s_mov_b32 s67, 0
    s_mov_b32 s17, 128
    s_mov_b32 s64, 20000
    s_mul_i32 s4, s48, 458752
    s_lshl_b32 s53, s47, 13
    s_add_u32 s4, s4, s53
    s_lshl_b32 s54, s46, 11
    s_add_u32 s4, s4, s54
    v_add_u32 v39, s54, v9
    s_mul_i32 s8, s50, 28672
    s_add_u32 s8, s8, s68
    s_and_b32 s54, s46, 1
    s_lshl_b32 s54, s54, 10
    s_lshr_b32 s55, s46, 1
    s_lshl_b32 s55, s55, 3
    s_add_u32 s54, s54, s55
    s_add_u32 s54, s54, 126976
    v_add_u32 v34, s54, v9
    v_add_u32 v35, 126976, v9
    v_lshlrev_b32 v60, 12, v1
    v_mov_b32 v61, 0x80
    v_bfe_u32 v10, v1, 3, 1
    v_lshlrev_b32 v10, 13, v10
    v_lshl_add_u32 v10, v11, 7, v10
    v_and_b32 v32, 7, v1
    v_lshl_add_u32 v36, v32, 4, v10
    s_lshl_b32 s53, s51, 17
    s_add_u32 s53, s53, 4194304
    s_lshl_b32 s54, s50, 9
    s_lshl_b32 s55, s46, 15
    s_add_u32 s54, s54, s55
    s_add_u32 s11, s54, s53
    s_add_u32 s12, s11, 16384
    v_lshrrev_b32 v10, 3, v1
    v_lshlrev_b32 v10, 9, v10
    v_lshl_add_u32 v37, v32, 4, v10
    s_lshl_b32 s54, s50, 13
    s_add_u32 s53, s53, s54
    s_lshl_b32 s54, s46, 7
    s_add_u32 s9, s53, s54
    s_add_u32 s10, s9, 4096
    v_lshlrev_b32 v38, 11, v32
    v_lshrrev_b32 v10, 5, v1
    v_lshl_add_u32 v38, v10, 2, v38
    v_bfe_u32 v10, v1, 4, 1
    v_lshl_add_u32 v38, v10, 1, v38
    s_and_b32 s53, s50, 3
    s_lshl_b32 s53, s53, 14
    s_lshl_b32 s54, s51, 7
    s_add_u32 s53, s53, s54
    s_lshr_b32 s54, s50, 2
    s_lshl_b32 s54, s54, 5
    s_add_u32 s53, s53, s54
    s_lshl_b32 s54, s46, 3
    s_add_u32 s53, s53, s54
    v_add_u32 v38, s53, v38
    v_mov_b32 v48, 0
    v_mov_b32 v49, 0
    v_mov_b32 v50, 0
    v_mov_b32 v51, 0
    v_mov_b32 v52, 0
    v_mov_b32 v53, 0
    v_mov_b32 v54, 0
    v_mov_b32 v55, 0
    v_and_b32 v10, 6, v1
    v_xor_b32 v10, v10, v11
    v_lshl_add_u32 v10, v32, 3, v10
    v_lshlrev_b32 v10, 4, v10
    v_bfe_u32 v32, v1, 3, 1
    v_lshl_add_u32 v10, v32, 13, v10
    v_add_u32 v5, 65536, v10
    v_xor_b32 v6, 64, v5
    v_mov_b32 v16, 0
    v_mov_b32 v17, 0
    v_mov_b32 v18, 0
    v_mov_b32 v19, 0
    v_mov_b32 v20, 0
    v_mov_b32 v21, 0
    v_mov_b32 v22, 0
    v_mov_b32 v23, 0
    s_cmp_ge_u32 s45, 24
    s_cbranch_scc1 L_light
    v_lshlrev_b32 v57, 7, v1
    s_bitcmp1_b32 s48, 0
    s_cselect_b32 s70, 0xffff, 0
    s_mov_b32 s71, 0
    s_lshl_b32 s53, s45, 2
    s_add_u32 s53, s53, s46
    s_mul_i32 s53, s53, 19
    v_add_u32 v10, s53, v1
    v_min_u32 v10, 1791, v10
    v_lshrrev_b32 v11, 2, v10
    v_and_b32 v10, 3, v10
    v_lshlrev_b32 v10, 9, v10
    v_lshl_add_u32 v58, v11, 11, v10
    s_mul_i32 s6, s44, 917504
    s_add_u32 s6, s6, 384
    s_waitcnt vmcnt(8)
    s_barrier
    ds_read_b128 v[128:131], v5 offset:0
    ds_read_b128 v[132:135], v5 offset:16384
    ds_read_b128 v[136:139], v6 offset:0
    ds_read_b128 v[140:143], v6 offset:16384
    ds_read_b64_tr_b16 v[64:65], v4 offset:0
    ds_read_b64_tr_b16 v[66:67], v4 offset:512
    ds_read_b64_tr_b16 v[68:69], v4 offset:4096
    ds_read_b64_tr_b16 v[70:71], v4 offset:4608
    ds_read_b128 v[144:147], v5 offset:1024
    ds_read_b128 v[148:151], v5 offset:17408
    ds_read_b128 v[152:155], v6 offset:1024
    ds_read_b128 v[156:159], v6 offset:17408
    s_add_u32 m0, s69, 69632
    s_add_u32 s53, s58, 512
    buffer_load_dwordx4 v3, s[20:23], s53 offen lds
    s_add_u32 m0, s68, 32768
    s_add_u32 s53, s57, 1835008
    buffer_load_dwordx4 v2, s[24:27], s53 offen nt lds
    s_add_u32 m0, s68, 36864
    s_add_u32 s53, s57, 2064384
    buffer_load_dwordx4 v2, s[24:27], s53 offen nt lds
    s_add_u32 m0, s69, 70656
    s_add_u32 s53, s58, 640
    buffer_load_dwordx4 v3, s[20:23], s53 offen lds
    s_waitcnt lgkmcnt(6)
    v_mfma_f32_16x16x32_bf16 v[16:19], v[64:67], v[128:131], v[16:19]
    v_mfma_f32_16x16x32_bf16 v[20:23], v[64:67], v[132:135], v[20:23]
    s_waitcnt lgkmcnt(4)
    v_mfma_f32_16x16x32_bf16 v[16:19], v[68:71], v[136:139], v[16:19]
    v_mfma_f32_16x16x32_bf16 v[20:23], v[68:71], v[140:143], v[20:23]
    s_waitcnt vmcnt(9)
    s_barrier
    ds_read_b64_tr_b16 v[72:73], v4 offset:8192
    ds_read_b64_tr_b16 v[74:75], v4 offset:8704
    ds_read_b64_tr_b16 v[76:77], v4 offset:12288
    ds_read_b64_tr_b16 v[78:79], v4 offset:12800
    ds_read_b128 v[160:163], v5 offset:2048
    ds_read_b128 v[164:167], v5 offset:18432
    ds_read_b128 v[168:171], v6 offset:2048
    ds_read_b128 v[172:175], v6 offset:18432
    s_add_u32 m0, s68, 40960
    s_add_u32 s53, s57, 2293760
    buffer_load_dwordx4 v2, s[24:27], s53 offen nt lds
    s_add_u32 m0, s68, 45056
    s_add_u32 s53, s57, 2523136
    buffer_load_dwordx4 v2, s[24:27], s53 offen nt lds
    s_mov_b64 exec, s[70:71]
    s_cbranch_execz L_nopre4
    buffer_load_dword v57, v57, s[40:43], s4 offen sc1
L_nopre4:
    s_mov_b64 exec, -1
    s_add_u32 m0, s69, 71680
    s_add_u32 s53, s58, 768
    buffer_load_dwordx4 v3, s[20:23], s53 offen lds
    s_waitcnt lgkmcnt(6)
    v_mfma_f32_16x16x32_bf16 v[16:19], v[72:75], v[144:147], v[16:19]
    v_mfma_f32_16x16x32_bf16 v[20:23], v[72:75], v[148:151], v[20:23]
    s_waitcnt lgkmcnt(4)
    v_mfma_f32_16x16x32_bf16 v[16:19], v[76:79], v[152:155], v[16:19]
    v_mfma_f32_16x16x32_bf16 v[20:23], v[76:79], v[156:159], v[20:23]
    s_waitcnt vmcnt(9)
    s_barrier
    ds_read_b64_tr_b16 v[80:81], v4 offset:16384
    ds_read_b64_tr_b16 v[82:83], v4 offset:16896
    ds_read_b64_tr_b16 v[84:85], v4 offset:20480
    ds_read_b64_tr_b16 v[86:87], v4 offset:20992
    ds_read_b128 v[176:179], v5 offset:3072
    ds_read_b128 v[180:183], v5 offset:19456
    ds_read_b128 v[184:187], v6 offset:3072
    ds_read_b128 v[188:191], v6 offset:19456
    s_add_u32 m0, s68, 49152
    s_add_u32 s53, s57, 2752512
    buffer_load_dwordx4 v2, s[24:27], s53 offen nt lds
    s_add_u32 m0, s68, 53248
    s_add_u32 s53, s57, 2981888
    buffer_load_dwordx4 v2, s[24:27], s53 offen nt lds
    s_add_u32 m0, s69, 72704
    s_add_u32 s53, s58, 896
    buffer_load_dwordx4 v3, s[20:23], s53 offen lds
    s_waitcnt lgkmcnt(6)
    v_mfma_f32_16x16x32_bf16 v[16:19], v[80:83], v[160:163], v[16:19]
    v_mfma_f32_16x16x32_bf16 v[20:23], v[80:83], v[164:167], v[20:23]
    s_waitcnt lgkmcnt(4)
    v_mfma_f32_16x16x32_bf16 v[16:19], v[84:87], v[168:171], v[16:19]
    v_mfma_f32_16x16x32_bf16 v[20:23], v[84:87], v[172:175], v[20:23]
    s_waitcnt vmcnt(9)
    s_barrier
    ds_read_b64_tr_b16 v[88:89], v4 offset:24576
    ds_read_b64_tr_b16 v[90:91], v4 offset:25088
    ds_read_b64_tr_b16 v[92:93], v4 offset:28672
    ds_read_b64_tr_b16 v[94:95], v4 offset:29184
    ds_read_b128 v[192:195], v5 offset:4096
    ds_read_b128 v[196:199], v5 offset:20480
    ds_read_b128 v[200:203], v6 offset:4096
    ds_read_b128 v[204:207], v6 offset:20480
    buffer_load_dword v13, v8, s[36:39], 0 offen sc1
    s_add_u32 m0, s68, 57344
    s_add_u32 s53, s57, 3211264
    buffer_load_dwordx4 v2, s[24:27], s53 offen nt lds
    s_add_u32 m0, s68, 61440
    s_add_u32 s53, s57, 3440640
    buffer_load_dwordx4 v2, s[24:27], s53 offen nt lds
    s_mov_b64 exec, 0x7ffff
    buffer_load_dword v58, v58, s[28:31], s6 offen
    s_mov_b64 exec, -1
    buffer_load_dword v59, v8, s[36:39], 0 offen sc1
    s_add_u32 m0, s68, 98304
    s_add_u32 s53, s59, 0
    buffer_load_dwordx4 v3, s[28:31], s53 offen nt lds
    s_waitcnt lgkmcnt(6)
    v_mfma_f32_16x16x32_bf16 v[16:19], v[88:91], v[176:179], v[16:19]
    v_mfma_f32_16x16x32_bf16 v[20:23], v[88:91], v[180:183], v[20:23]
    s_waitcnt lgkmcnt(4)
    v_mfma_f32_16x16x32_bf16 v[16:19], v[92:95], v[184:187], v[16:19]
    v_mfma_f32_16x16x32_bf16 v[20:23], v[92:95], v[188:191], v[20:23]
    s_waitcnt vmcnt(12)
    s_barrier
    ds_read_b64_tr_b16 v[96:97], v4 offset:32768
    ds_read_b64_tr_b16 v[98:99], v4 offset:33280
    ds_read_b64_tr_b16 v[100:101], v4 offset:36864
    ds_read_b64_tr_b16 v[102:103], v4 offset:37376
    ds_read_b128 v[208:211], v5 offset:5120
    ds_read_b128 v[212:215], v5 offset:21504
    ds_read_b128 v[216:219], v6 offset:5120
    ds_read_b128 v[220:223], v6 offset:21504
    s_add_u32 m0, s68, 102400
    s_add_u32 s53, s59, 65536
    buffer_load_dwordx4 v3, s[28:31], s53 offen nt lds
    s_waitcnt lgkmcnt(6)
    v_mfma_f32_16x16x32_bf16 v[16:19], v[96:99], v[192:195], v[16:19]
    v_mfma_f32_16x16x32_bf16 v[20:23], v[96:99], v[196:199], v[20:23]
    s_waitcnt lgkmcnt(4)
    v_mfma_f32_16x16x32_bf16 v[16:19], v[100:103], v[200:203], v[16:19]
    v_mfma_f32_16x16x32_bf16 v[20:23], v[100:103], v[204:207], v[20:23]
    s_waitcnt vmcnt(10)
    s_barrier
    ds_read_b64_tr_b16 v[104:105], v4 offset:40960
    ds_read_b64_tr_b16 v[106:107], v4 offset:41472
    ds_read_b64_tr_b16 v[108:109], v4 offset:45056
    ds_read_b64_tr_b16 v[110:111], v4 offset:45568
    ds_read_b128 v[224:227], v5 offset:6144
    ds_read_b128 v[228:231], v5 offset:22528
    ds_read_b128 v[232:235], v6 offset:6144
    ds_read_b128 v[236:239], v6 offset:22528
    s_waitcnt lgkmcnt(6)
    v_mfma_f32_16x16x32_bf16 v[16:19], v[104:107], v[208:211], v[16:19]
    v_mfma_f32_16x16x32_bf16 v[20:23], v[104:107], v[212:215], v[20:23]
    s_waitcnt lgkmcnt(4)
    v_mfma_f32_16x16x32_bf16 v[16:19], v[108:111], v[216:219], v[16:19]
    v_mfma_f32_16x16x32_bf16 v[20:23], v[108:111], v[220:223], v[20:23]
    s_waitcnt vmcnt(7)
    s_barrier
    ds_read_b64_tr_b16 v[112:113], v4 offset:49152
    ds_read_b64_tr_b16 v[114:115], v4 offset:49664
    ds_read_b64_tr_b16 v[116:117], v4 offset:53248
    ds_read_b64_tr_b16 v[118:119], v4 offset:53760
    ds_read_b128 v[240:243], v5 offset:7168
    ds_read_b128 v[244:247], v5 offset:23552
    ds_read_b128 v[248:251], v6 offset:7168
    ds_read_b128 v[252:255], v6 offset:23552
    s_waitcnt lgkmcnt(6)
    v_mfma_f32_16x16x32_bf16 v[16:19], v[112:115], v[224:227], v[16:19]
    v_mfma_f32_16x16x32_bf16 v[20:23], v[112:115], v[228:231], v[20:23]
    s_waitcnt lgkmcnt(4)
    v_mfma_f32_16x16x32_bf16 v[16:19], v[116:119], v[232:235], v[16:19]
    v_mfma_f32_16x16x32_bf16 v[20:23], v[116:119], v[236:239], v[20:23]
    s_waitcnt vmcnt(4)
    s_barrier
    ds_read_b64_tr_b16 v[120:121], v4 offset:57344
    ds_read_b64_tr_b16 v[122:123], v4 offset:57856
    ds_read_b64_tr_b16 v[124:125], v4 offset:61440
    ds_read_b64_tr_b16 v[126:127], v4 offset:61952
    v_readfirstlane_b32 s52, v13
    s_waitcnt lgkmcnt(2)
    v_mfma_f32_16x16x32_bf16 v[16:19], v[120:123], v[240:243], v[16:19]
    v_mfma_f32_16x16x32_bf16 v[20:23], v[120:123], v[244:247], v[20:23]
    s_waitcnt lgkmcnt(0)
    v_mfma_f32_16x16x32_bf16 v[16:19], v[124:127], v[248:251], v[16:19]
    v_mfma_f32_16x16x32_bf16 v[20:23], v[124:127], v[252:255], v[20:23]
    s_cmp_eq_u32 s52, 0
    s_cbranch_scc1 L_tau1_slow
L_tau1_ok:
    s_nop 4
    v_perm_b32 v16, v16, v13, s60
    v_perm_b32 v17, v17, v13, s61
    v_perm_b32 v18, v18, v13, s62
    v_perm_b32 v19, v19, v13, s63
    buffer_store_dwordx4 v[16:19], v9, s[40:43], s4 offen offset:0
    v_perm_b32 v20, v20, v13, s60
    v_perm_b32 v21, v21, v13, s61
    v_perm_b32 v22, v22, v13, s62
    v_perm_b32 v23, v23, v13, s63
    buffer_store_dwordx4 v[20:23], v9, s[40:43], s4 offen offset:1024
    s_barrier
    s_add_u32 m0, s68, 106496
    s_add_u32 s53, s59, 131072
    buffer_load_dwordx4 v3, s[28:31], s53 offen nt lds
    s_add_u32 m0, s68, 110592
    s_add_u32 s53, s59, 196608
    buffer_load_dwordx4 v3, s[28:31], s53 offen nt lds
    s_add_u32 m0, s68, 114688
    s_add_u32 s53, s59, 262144
    buffer_load_dwordx4 v3, s[28:31], s53 offen nt lds
    s_add_u32 m0, s68, 118784
    s_add_u32 s53, s59, 327680
    buffer_load_dwordx4 v3, s[28:31], s53 offen nt lds
    s_add_u32 m0, s68, 122880
    s_add_u32 s53, s59, 393216
    buffer_load_dwordx4 v3, s[28:31], s53 offen nt lds
    ds_write_b128 v39, v[16:19] offset:0
    ds_write_b128 v39, v[20:23] offset:1024
    v_alignbit_b32 v12, v13, v13, 16
    v_not_b32 v12, v12
    v_mov_b32 v14, v13
    v_mov_b32 v15, v13
    s_waitcnt vmcnt(0)
L_phase2:
    s_add_u32 s53, s8, s67
    buffer_load_dwordx4 v[64:67], v9, s[40:43], s53 offen sc1
    s_add_u32 s53, s53, 4096
    buffer_load_dwordx4 v[68:71], v9, s[40:43], s53 offen sc1
    s_add_u32 s53, s53, 4096
    buffer_load_dwordx4 v[72:75], v9, s[40:43], s53 offen sc1
    s_add_u32 s53, s53, 4096
    buffer_load_dwordx4 v[76:79], v9, s[40:43], s53 offen sc1
    s_add_u32 s53, s53, 4096
    buffer_load_dwordx4 v[80:83], v9, s[40:43], s53 offen sc1
    s_add_u32 s53, s53, 4096
    buffer_load_dwordx4 v[84:87], v9, s[40:43], s53 offen sc1
    s_add_u32 s53, s53, 4096
    buffer_load_dwordx4 v[88:91], v9, s[40:43], s53 offen sc1
    s_waitcnt vmcnt(7)
    s_barrier
    ds_read_b64_tr_b16 v[192:193], v7 offset:0
    ds_read_b64_tr_b16 v[194:195], v7 offset:2048
    ds_read_b64_tr_b16 v[196:197], v7 offset:4096
    ds_read_b64_tr_b16 v[198:199], v7 offset:6144
    ds_read_b64_tr_b16 v[200:201], v7 offset:8192
    ds_read_b64_tr_b16 v[202:203], v7 offset:10240
    ds_read_b64_tr_b16 v[204:205], v7 offset:12288
    ds_read_b64_tr_b16 v[206:207], v7 offset:14336
    ds_read_b64_tr_b16 v[208:209], v7 offset:16384
    ds_read_b64_tr_b16 v[210:211], v7 offset:18432
    ds_read_b64_tr_b16 v[212:213], v7 offset:20480
    ds_read_b64_tr_b16 v[214:215], v7 offset:22528
    ds_read_b64_tr_b16 v[216:217], v7 offset:24576
    ds_read_b64_tr_b16 v[218:219], v7 offset:26624
    s_waitcnt vmcnt(6)
    ds_write_b64 v34, v[64:65] offset:0
    v_cmp_ne_u64 s[70:71], v[66:67], v[12:13]
    s_waitcnt vmcnt(5)
    ds_write_b64 v34, v[68:69] offset:2048
    v_cmp_ne_u64 s[72:73], v[70:71], v[12:13]
    s_waitcnt vmcnt(4)
    ds_write_b64 v34, v[72:73] offset:4096
    v_cmp_ne_u64 s[74:75], v[74:75], v[12:13]
    s_waitcnt vmcnt(3)
    ds_write_b64 v34, v[76:77] offset:6144
    v_cmp_ne_u64 s[76:77], v[78:79], v[12:13]
    s_waitcnt vmcnt(2)
    ds_write_b64 v34, v[80:81] offset:8192
    v_cmp_ne_u64 s[78:79], v[82:83], v[12:13]
    s_waitcnt vmcnt(1)
    ds_write_b64 v34, v[84:85] offset:10240
    v_cmp_ne_u64 s[80:81], v[86:87], v[12:13]
    s_waitcnt vmcnt(0)
    ds_write_b64 v34, v[88:89] offset:12288
    v_cmp_ne_u64 s[82:83], v[90:91], v[12:13]
    s_or_b64 vcc, s[70:71], s[72:73]
    s_or_b64 vcc, vcc, s[74:75]
    s_or_b64 vcc, vcc, s[76:77]
    s_or_b64 vcc, vcc, s[78:79]
    s_or_b64 vcc, vcc, s[80:81]
    s_or_b64 vcc, vcc, s[82:83]
    s_cbranch_scc1 L_retryB
L_doneB:
    s_waitcnt lgkmcnt(0)
    s_barrier
    ds_read_b128 v[128:131], v35 offset:0
    ds_read_b128 v[136:139], v35 offset:2048
    ds_read_b128 v[144:147], v35 offset:4096
    ds_read_b128 v[152:155], v35 offset:6144
    ds_read_b128 v[160:163], v35 offset:8192
    ds_read_b128 v[168:171], v35 offset:10240
    ds_read_b128 v[176:179], v35 offset:12288
    ds_read_b128 v[132:135], v35 offset:1024
    ds_read_b128 v[140:143], v35 offset:3072
    ds_read_b128 v[148:151], v35 offset:5120
    ds_read_b128 v[156:159], v35 offset:7168
    ds_read_b128 v[164:167], v35 offset:9216
    ds_read_b128 v[172:175], v35 offset:11264
    ds_read_b128 v[180:183], v35 offset:13312
    s_waitcnt lgkmcnt(13)
    v_mfma_f32_16x16x32_bf16 v[48:51], v[192:195], v[128:131], v[48:51]
    s_waitcnt lgkmcnt(12)
    v_mfma_f32_16x16x32_bf16 v[48:51], v[196:199], v[136:139], v[48:51]
    s_waitcnt lgkmcnt(11)
    v_mfma_f32_16x16x32_bf16 v[48:51], v[200:203], v[144:147], v[48:51]
    s_waitcnt lgkmcnt(10)
    v_mfma_f32_16x16x32_bf16 v[48:51], v[204:207], v[152:155], v[48:51]
    s_waitcnt lgkmcnt(9)
    v_mfma_f32_16x16x32_bf16 v[48:51], v[208:211], v[160:163], v[48:51]
    s_waitcnt lgkmcnt(8)
    v_mfma_f32_16x16x32_bf16 v[48:51], v[212:215], v[168:171], v[48:51]
    s_waitcnt lgkmcnt(7)
    v_mfma_f32_16x16x32_bf16 v[48:51], v[216:219], v[176:179], v[48:51]
    s_waitcnt lgkmcnt(6)
    v_mfma_f32_16x16x32_bf16 v[52:55], v[192:195], v[132:135], v[52:55]
    s_waitcnt lgkmcnt(5)
    v_mfma_f32_16x16x32_bf16 v[52:55], v[196:199], v[140:143], v[52:55]
    s_waitcnt lgkmcnt(4)
    v_mfma_f32_16x16x32_bf16 v[52:55], v[200:203], v[148:151], v[52:55]
    s_waitcnt lgkmcnt(3)
    v_mfma_f32_16x16x32_bf16 v[52:55], v[204:207], v[156:159], v[52:55]
    s_waitcnt lgkmcnt(2)
    v_mfma_f32_16x16x32_bf16 v[52:55], v[208:211], v[164:167], v[52:55]
    v_perm_b32 v48, v48, v13, s60
    v_perm_b32 v49, v49, v13, s61
    v_perm_b32 v50, v50, v13, s62
    v_perm_b32 v51, v51, v13, s63
    buffer_store_dwordx4 v[48:51], v36, s[40:43], s11 offen sc1
    s_waitcnt lgkmcnt(1)
    v_mfma_f32_16x16x32_bf16 v[52:55], v[212:215], v[172:175], v[52:55]
    s_waitcnt lgkmcnt(0)
    v_mfma_f32_16x16x32_bf16 v[52:55], v[216:219], v[180:183], v[52:55]
    s_nop 7
    v_perm_b32 v52, v52, v13, s60
    v_perm_b32 v53, v53, v13, s61
    v_perm_b32 v54, v54, v13, s62
    v_perm_b32 v55, v55, v13, s63
    buffer_store_dwordx4 v[52:55], v36, s[40:43], s12 offen sc1
L_pollC0:
    s_waitcnt vmcnt(0)
L_pollC:
    buffer_load_dwordx4 v[24:27], v37, s[40:43], s9 offen sc1
    buffer_load_dwordx4 v[28:31], v37, s[40:43], s10 offen sc1
    s_sub_u32 s17, s17, 1
    s_cbranch_scc1 L_pc_slow
L_pc_back:
    s_waitcnt vmcnt(1)
    v_perm_b32 v10, v25, v24, s13
    v_perm_b32 v32, v27, v26, s14
    v_perm_b32 v24, v24, v61, s60
    v_perm_b32 v25, v25, v61, s60
    v_perm_b32 v26, v26, v61, s60
    v_perm_b32 v27, v27, v61, s60
    s_waitcnt vmcnt(0)
    v_perm_b32 v11, v29, v28, s13
    v_perm_b32 v33, v31, v30, s14
    v_or_b32 v10, v10, v32
    v_or_b32 v11, v11, v33
    v_cmp_ne_u64 vcc, v[10:11], v[14:15]
    v_perm_b32 v28, v28, v61, s60
    v_perm_b32 v29, v29, v61, s60
    v_perm_b32 v30, v30, v61, s60
    v_perm_b32 v31, v31, v61, s60
    v_add_f32 v24, v24, v28
    v_add_f32 v25, v25, v29
    v_add_f32 v26, v26, v30
    v_add_f32 v27, v27, v31
    s_cbranch_vccnz L_pollC
    v_permlane32_swap_b32 v24, v26
    v_permlane32_swap_b32 v25, v27
    s_nop 0
    v_add_f32 v24, v24, v26
    v_add_f32 v25, v25, v27
    s_nop 1
    v_permlane16_swap_b32 v24, v25
    s_nop 0
    v_add_f32 v24, v24, v25
    s_nop 1
    v_add_f32_dpp v24, v24, v24 row_ror:8 row_mask:0xf bank_mask:0xf
    v_cvt_pk_bf16_f32 v24, v24, v24
    s_mov_b32 exec_lo, 0x00ff00ff
    s_mov_b32 exec_hi, 0x00ff00ff
    buffer_store_short v24, v38, s[32:35], 0 offen
L_end:
    s_endpgm
L_retryB:
    s_mov_b32 s58, 0
    s_cmp_lg_u64 s[70:71], 0
    s_cselect_b32 s54, 1, 0
    s_or_b32 s58, s58, s54
    s_cmp_lg_u64 s[72:73], 0
    s_cselect_b32 s54, 2, 0
    s_or_b32 s58, s58, s54
    s_cmp_lg_u64 s[74:75], 0
    s_cselect_b32 s54, 4, 0
    s_or_b32 s58, s58, s54
    s_cmp_lg_u64 s[76:77], 0
    s_cselect_b32 s54, 8, 0
    s_or_b32 s58, s58, s54
    s_cmp_lg_u64 s[78:79], 0
    s_cselect_b32 s54, 16, 0
    s_or_b32 s58, s58, s54
    s_cmp_lg_u64 s[80:81], 0
    s_cselect_b32 s54, 32, 0
    s_or_b32 s58, s58, s54
    s_cmp_lg_u64 s[82:83], 0
    s_cselect_b32 s54, 64, 0
    s_or_b32 s58, s58, s54
    s_bcnt1_i32_b32 s53, s58
    s_cmp_gt_u32 s53, 2
    s_cbranch_scc1 L_watch
L_rbloop:
    s_sub_u32 s17, s17, 1
    s_cbranch_scc1 L_rb_slow
L_rb_back:
    s_xor_b32 s67, s67, s66
    s_add_u32 s56, s8, s67
    s_ff1_i32_b32 s57, s58
    s_lshl_b32 s53, s57, 12
    s_add_u32 s53, s53, s56
    buffer_load_dwordx4 v[64:67], v9, s[40:43], s53 offen sc1
    s_flbit_i32_b32 s49, s58
    s_sub_u32 s49, 31, s49
    s_lshl_b32 s53, s49, 12
    s_add_u32 s53, s53, s56
    buffer_load_dwordx4 v[68:71], v9, s[40:43], s53 offen sc1
    s_lshl_b32 s53, s57, 11
    s_lshl_b32 s54, s49, 11
    v_add_u32 v10, s53, v34
    v_add_u32 v11, s54, v34
    s_waitcnt vmcnt(1)
    v_cmp_ne_u64 s[70:71], v[66:67], v[12:13]
    ds_write_b64 v10, v[64:65]
    s_waitcnt vmcnt(0)
    v_cmp_ne_u64 s[72:73], v[70:71], v[12:13]
    ds_write_b64 v11, v[68:69]
    s_cmp_eq_u64 s[70:71], 0
    s_cselect_b32 s53, s57, 31
    s_bitset0_b32 s58, s53
    s_bitset1_b32 s58, s49
    s_cmp_eq_u64 s[72:73], 0
    s_cselect_b32 s53, s49, 31
    s_bitset0_b32 s58, s53
    s_cmp_lg_u32 s58, 0
    s_cbranch_scc1 L_rbloop
    s_branch L_doneB
L_watch:
    s_sub_u32 s17, s17, 1
    s_cbranch_scc1 L_wa_slow
L_wa_back:
    s_xor_b32 s67, s67, s66
    s_add_u32 s53, s8, s67
    s_mov_b64 exec, 0x7f
    buffer_load_dwordx2 v[62:63], v60, s[40:43], s53 offen offset:1016 sc1
    s_waitcnt vmcnt(0)
    v_cmp_ne_u64 vcc, v[62:63], v[12:13]
    s_mov_b64 exec, -1
    s_bcnt1_i32_b32 s54, vcc_lo
    s_cmp_gt_u32 s54, 2
    s_cbranch_scc1 L_watch
    buffer_load_dwordx4 v[64:67], v9, s[40:43], s53 offen sc1
    s_add_u32 s53, s53, 4096
    buffer_load_dwordx4 v[68:71], v9, s[40:43], s53 offen sc1
    s_add_u32 s53, s53, 4096
    buffer_load_dwordx4 v[72:75], v9, s[40:43], s53 offen sc1
    s_add_u32 s53, s53, 4096
    buffer_load_dwordx4 v[76:79], v9, s[40:43], s53 offen sc1
    s_add_u32 s53, s53, 4096
    buffer_load_dwordx4 v[80:83], v9, s[40:43], s53 offen sc1
    s_add_u32 s53, s53, 4096
    buffer_load_dwordx4 v[84:87], v9, s[40:43], s53 offen sc1
    s_add_u32 s53, s53, 4096
    buffer_load_dwordx4 v[88:91], v9, s[40:43], s53 offen sc1
    s_waitcnt vmcnt(6)
    ds_write_b64 v34, v[64:65] offset:0
    v_cmp_ne_u64 s[70:71], v[66:67], v[12:13]
    s_waitcnt vmcnt(5)
    ds_write_b64 v34, v[68:69] offset:2048
    v_cmp_ne_u64 s[72:73], v[70:71], v[12:13]
    s_waitcnt vmcnt(4)
    ds_write_b64 v34, v[72:73] offset:4096
    v_cmp_ne_u64 s[74:75], v[74:75], v[12:13]
    s_waitcnt vmcnt(3)
    ds_write_b64 v34, v[76:77] offset:6144
    v_cmp_ne_u64 s[76:77], v[78:79], v[12:13]
    s_waitcnt vmcnt(2)
    ds_write_b64 v34, v[80:81] offset:8192
    v_cmp_ne_u64 s[78:79], v[82:83], v[12:13]
    s_waitcnt vmcnt(1)
    ds_write_b64 v34, v[84:85] offset:10240
    v_cmp_ne_u64 s[80:81], v[86:87], v[12:13]
    s_waitcnt vmcnt(0)
    ds_write_b64 v34, v[88:89] offset:12288
    v_cmp_ne_u64 s[82:83], v[90:91], v[12:13]
    s_or_b64 vcc, s[70:71], s[72:73]
    s_or_b64 vcc, vcc, s[74:75]
    s_or_b64 vcc, vcc, s[76:77]
    s_or_b64 vcc, vcc, s[78:79]
    s_or_b64 vcc, vcc, s[80:81]
    s_or_b64 vcc, vcc, s[82:83]
    s_cbranch_scc1 L_retryB
    s_branch L_doneB
L_tau1_slow:
    s_waitcnt vmcnt(0)
    v_mov_b32 v13, v59
    s_mov_b32 s56, 2560000
L_tau1:
    v_readfirstlane_b32 s52, v13
    s_cmp_lg_u32 s52, 0
    s_cbranch_scc1 L_tau1_ok
    buffer_load_dword v13, v8, s[36:39], 0 offen sc1
    s_sub_u32 s56, s56, 1
    s_cbranch_scc1 L_end
    s_waitcnt vmcnt(0)
    s_branch L_tau1
L_light:
    s_cmp_ge_u32 s48, s49
    s_addc_u32 s53, s48, 0
    s_mul_i32 s7, s44, 7
    s_add_u32 s7, s7, s53
    s_sub_u32 s54, s48, 6
    s_lshl_b32 s54, s54, 10
    s_movk_i32 s6, 1024
    s_cmp_ge_u32 s48, 6
    s_cselect_b32 s7, s47, s7
    s_cselect_b32 s54, s54, 0
    s_cselect_b32 s6, 1835008, s6
    s_cselect_b32 s70, -1, 0x00ff00ff
    s_mov_b32 s71, s70
    s_lshl_b32 s5, s7, 13
    s_add_u32 s5, s5, s54
    s_lshl_b32 s54, s46, 11
    s_add_u32 s5, s5, s54
    v_bfe_u32 v10, v1, 3, 2
    v_mul_u32_u24 v10, 458752, v10
    v_lshrrev_b32 v11, 5, v1
    v_mul_lo_u32 v11, v11, s6
    v_and_b32 v32, 7, v1
    v_lshlrev_b32 v32, 7, v32
    v_add3_u32 v57, v10, v11, v32
    s_mov_b32 s7, s5
    v_mov_b32 v56, 0xc0135761
    s_mov_b32 s65, 0xbdd2d3e8
    s_cmp_lg_u32 s82, 0
    s_cbranch_scc1 L_assist
    s_waitcnt vmcnt(8)
    s_barrier
    ds_read_b128 v[128:131], v5 offset:0
    ds_read_b128 v[132:135], v5 offset:16384
    ds_read_b128 v[136:139], v6 offset:0
    ds_read_b128 v[140:143], v6 offset:16384
    ds_read_b64_tr_b16 v[64:65], v4 offset:0
    ds_read_b64_tr_b16 v[66:67], v4 offset:512
    ds_read_b64_tr_b16 v[68:69], v4 offset:4096
    ds_read_b64_tr_b16 v[70:71], v4 offset:4608
    ds_read_b128 v[144:147], v5 offset:1024
    ds_read_b128 v[148:151], v5 offset:17408
    ds_read_b128 v[152:155], v6 offset:1024
    ds_read_b128 v[156:159], v6 offset:17408
    s_mov_b64 exec, s[70:71]
    s_cbranch_execz L_nopre5
    buffer_load_dword v57, v57, s[40:43], s5 offen sc1
L_nopre5:
    s_mov_b64 exec, -1
    buffer_load_dword v13, v8, s[36:39], 0 offen sc1
    s_waitcnt lgkmcnt(6)
    v_mfma_f32_16x16x32_bf16 v[16:19], v[64:67], v[128:131], v[16:19]
    v_mfma_f32_16x16x32_bf16 v[20:23], v[64:67], v[132:135], v[20:23]
    s_waitcnt lgkmcnt(4)
    v_mfma_f32_16x16x32_bf16 v[16:19], v[68:71], v[136:139], v[16:19]
    v_mfma_f32_16x16x32_bf16 v[20:23], v[68:71], v[140:143], v[20:23]
    s_waitcnt vmcnt(6)
    s_barrier
    ds_read_b64_tr_b16 v[72:73], v4 offset:8192
    ds_read_b64_tr_b16 v[74:75], v4 offset:8704
    ds_read_b64_tr_b16 v[76:77], v4 offset:12288
    ds_read_b64_tr_b16 v[78:79], v4 offset:12800
    ds_read_b128 v[160:163], v5 offset:2048
    ds_read_b128 v[164:167], v5 offset:18432
    ds_read_b128 v[168:171], v6 offset:2048
    ds_read_b128 v[172:175], v6 offset:18432
    s_waitcnt lgkmcnt(6)
    v_mfma_f32_16x16x32_bf16 v[16:19], v[72:75], v[144:147], v[16:19]
    v_mfma_f32_16x16x32_bf16 v[20:23], v[72:75], v[148:151], v[20:23]
    s_waitcnt lgkmcnt(4)
    v_mfma_f32_16x16x32_bf16 v[16:19], v[76:79], v[152:155], v[16:19]
    v_mfma_f32_16x16x32_bf16 v[20:23], v[76:79], v[156:159], v[20:23]
    s_waitcnt vmcnt(3)
    s_barrier
    ds_read_b64_tr_b16 v[80:81], v4 offset:16384
    ds_read_b64_tr_b16 v[82:83], v4 offset:16896
    ds_read_b64_tr_b16 v[84:85], v4 offset:20480
    ds_read_b64_tr_b16 v[86:87], v4 offset:20992
    ds_read_b128 v[176:179], v5 offset:3072
    ds_read_b128 v[180:183], v5 offset:19456
    ds_read_b128 v[184:187], v6 offset:3072
    ds_read_b128 v[188:191], v6 offset:19456
    s_waitcnt lgkmcnt(6)
    v_mfma_f32_16x16x32_bf16 v[16:19], v[80:83], v[160:163], v[16:19]
    v_mfma_f32_16x16x32_bf16 v[20:23], v[80:83], v[164:167], v[20:23]
    s_waitcnt lgkmcnt(4)
    v_mfma_f32_16x16x32_bf16 v[16:19], v[84:87], v[168:171], v[16:19]
    v_mfma_f32_16x16x32_bf16 v[20:23], v[84:87], v[172:175], v[20:23]
    s_waitcnt vmcnt(1)
    s_barrier
    ds_read_b64_tr_b16 v[88:89], v4 offset:24576
    ds_read_b64_tr_b16 v[90:91], v4 offset:25088
    ds_read_b64_tr_b16 v[92:93], v4 offset:28672
    ds_read_b64_tr_b16 v[94:95], v4 offset:29184
    s_waitcnt lgkmcnt(2)
    v_mfma_f32_16x16x32_bf16 v[16:19], v[88:91], v[176:179], v[16:19]
    v_mfma_f32_16x16x32_bf16 v[20:23], v[88:91], v[180:183], v[20:23]
    s_waitcnt lgkmcnt(0)
    v_mfma_f32_16x16x32_bf16 v[16:19], v[92:95], v[184:187], v[16:19]
    v_mfma_f32_16x16x32_bf16 v[20:23], v[92:95], v[188:191], v[20:23]
    s_waitcnt vmcnt(0)
    s_mov_b32 s56, 2560000
L_tau2:
    v_readfirstlane_b32 s52, v13
    s_cmp_lg_u32 s52, 0
    s_cbranch_scc1 L_tau2_ok
    buffer_load_dword v13, v8, s[36:39], 0 offen sc1
    s_sub_u32 s56, s56, 1
    s_cbranch_scc1 L_end
    s_waitcnt vmcnt(0)
    s_branch L_tau2
L_tau2_ok:
    s_nop 3
    v_perm_b32 v16, v16, v13, s60
    v_perm_b32 v17, v17, v13, s61
    v_perm_b32 v18, v18, v13, s62
    v_perm_b32 v19, v19, v13, s63
    buffer_store_dwordx4 v[16:19], v9, s[40:43], s4 offen offset:0
    v_perm_b32 v20, v20, v13, s60
    v_perm_b32 v21, v21, v13, s61
    v_perm_b32 v22, v22, v13, s62
    v_perm_b32 v23, v23, v13, s63
    buffer_store_dwordx4 v[20:23], v9, s[40:43], s4 offen offset:1024
    ds_write_b128 v39, v[16:19] offset:0
    ds_write_b128 v39, v[20:23] offset:1024
    v_alignbit_b32 v12, v13, v13, 16
    v_not_b32 v12, v12
    v_mov_b32 v14, v13
    v_mov_b32 v15, v13
    v_mov_b32 v42, v12
    v_mov_b32 v43, v13
    s_cmp_ge_u32 s48, 6
    s_cbranch_scc1 L_slowfin
L_pollGm:
    s_xor_b32 s16, s16, s15
    s_add_u32 s56, s5, s16
    s_add_u32 s53, s56, 0
    buffer_load_dwordx4 v[64:67], v9, s[40:43], s53 offen sc1
    s_add_u32 s53, s56, 917504
    buffer_load_dwordx4 v[72:75], v9, s[40:43], s53 offen sc1
    s_sub_u32 s17, s17, 1
    s_cbranch_scc1 L_pgm_slow
L_pgm_back:
    s_waitcnt vmcnt(0)
    v_perm_b32 v10, v65, v64, s13
    v_perm_b32 v32, v67, v66, s14
    v_perm_b32 v11, v73, v72, s13
    v_perm_b32 v33, v75, v74, s14
    v_or_b32 v10, v10, v32
    v_or_b32 v11, v11, v33
    v_cmp_ne_u64 vcc, v[10:11], v[14:15]
    v_perm_b32 v104, v64, v61, s60
    v_perm_b32 v105, v65, v61, s60
    v_perm_b32 v106, v66, v61, s60
    v_perm_b32 v107, v67, v61, s60
    v_perm_b32 v108, v72, v61, s60
    v_perm_b32 v109, v73, v61, s60
    v_perm_b32 v110, v74, v61, s60
    v_perm_b32 v111, v75, v61, s60
    v_add_f32 v96, v104, v108
    v_add_f32 v97, v105, v109
    v_add_f32 v98, v106, v110
    v_add_f32 v99, v107, v111
    s_cbranch_vccnz L_pollGm
    s_xor_b32 s16, s16, s15
    s_add_u32 s56, s5, s16
    s_add_u32 s53, s56, 458752
    buffer_load_dwordx4 v[68:71], v9, s[40:43], s53 offen sc1
    s_add_u32 s53, s56, 1376256
    buffer_load_dwordx4 v[76:79], v9, s[40:43], s53 offen sc1
    s_cmp_lg_u32 s82, 0
    s_cbranch_scc1 L_noDm
    s_add_u32 m0, s68, 98304
    s_add_u32 s53, s59, 0
    buffer_load_dwordx4 v3, s[28:31], s53 offen nt lds
    s_add_u32 m0, s68, 102400
    s_add_u32 s53, s59, 65536
    buffer_load_dwordx4 v3, s[28:31], s53 offen nt lds
    s_add_u32 m0, s68, 106496
    s_add_u32 s53, s59, 131072
    buffer_load_dwordx4 v3, s[28:31], s53 offen nt lds
    s_add_u32 m0, s68, 110592
    s_add_u32 s53, s59, 196608
    buffer_load_dwordx4 v3, s[28:31], s53 offen nt lds
L_noDm:
    v_cvt_pk_bf16_f32 v97, v96, v97
    v_cvt_pk_bf16_f32 v99, v98, v99
    v_lshlrev_b32 v96, 16, v97
    v_and_b32 v97, 0xffff0000, v97
    v_lshlrev_b32 v98, 16, v99
    v_and_b32 v99, 0xffff0000, v99
    v_mul_f32 v120, v96, v96
    v_mul_f32 v121, v97, v97
    v_mul_f32 v122, v98, v98
    v_mul_f32 v123, v99, v99
    v_fma_f32 v120, v120, s65, v56
    v_fma_f32 v121, v121, s65, v56
    v_fma_f32 v122, v122, s65, v56
    v_fma_f32 v123, v123, s65, v56
    v_mul_f32 v120, v120, v96
    v_mul_f32 v121, v121, v97
    v_mul_f32 v122, v122, v98
    v_mul_f32 v123, v123, v99
    v_exp_f32 v120, v120
    v_exp_f32 v121, v121
    v_exp_f32 v122, v122
    v_exp_f32 v123, v123
    v_add_f32 v120, 1.0, v120
    v_add_f32 v121, 1.0, v121
    v_add_f32 v122, 1.0, v122
    v_add_f32 v123, 1.0, v123
    v_rcp_f32 v120, v120
    v_rcp_f32 v121, v121
    v_rcp_f32 v122, v122
    v_rcp_f32 v123, v123
    v_mul_f32 v120, v120, v96
    v_mul_f32 v121, v121, v97
    v_mul_f32 v122, v122, v98
    v_mul_f32 v123, v123, v99
    v_cvt_pk_bf16_f32 v121, v120, v121
    v_cvt_pk_bf16_f32 v123, v122, v123
    v_lshlrev_b32 v120, 16, v121
    v_and_b32 v121, 0xffff0000, v121
    v_lshlrev_b32 v122, 16, v123
    v_and_b32 v123, 0xffff0000, v123
    s_cmp_lg_u32 s82, 0
    s_cbranch_scc1 L_wUm
    s_waitcnt vmcnt(4)
    s_branch L_ckUm
L_pollUm:
    s_xor_b32 s16, s16, s15
    s_add_u32 s56, s5, s16
    s_add_u32 s53, s56, 458752
    buffer_load_dwordx4 v[68:71], v9, s[40:43], s53 offen sc1
    s_add_u32 s53, s56, 1376256
    buffer_load_dwordx4 v[76:79], v9, s[40:43], s53 offen sc1
    s_sub_u32 s17, s17, 1
    s_cbranch_scc1 L_pum_slow
L_pum_back:
L_wUm:
    s_waitcnt vmcnt(0)
L_ckUm:
    v_perm_b32 v10, v69, v68, s13
    v_perm_b32 v32, v71, v70, s14
    v_perm_b32 v11, v77, v76, s13
    v_perm_b32 v33, v79, v78, s14
    v_or_b32 v10, v10, v32
    v_or_b32 v11, v11, v33
    v_cmp_ne_u64 vcc, v[10:11], v[14:15]
    v_perm_b32 v104, v68, v61, s60
    v_perm_b32 v105, v69, v61, s60
    v_perm_b32 v106, v70, v61, s60
    v_perm_b32 v107, v71, v61, s60
    v_perm_b32 v108, v76, v61, s60
    v_perm_b32 v109, v77, v61, s60
    v_perm_b32 v110, v78, v61, s60
    v_perm_b32 v111, v79, v61, s60
    v_add_f32 v100, v104, v108
    v_add_f32 v101, v105, v109
    v_add_f32 v102, v106, v110
    v_add_f32 v103, v107, v111
    s_cbranch_vccnz L_pollUm
    v_cvt_pk_bf16_f32 v101, v100, v101
    v_cvt_pk_bf16_f32 v103, v102, v103
    v_lshlrev_b32 v100, 16, v101
    v_and_b32 v101, 0xffff0000, v101
    v_lshlrev_b32 v102, 16, v103
    v_and_b32 v103, 0xffff0000, v103
    v_mul_f32 v100, v100, v120
    v_mul_f32 v101, v101, v121
    v_mul_f32 v102, v102, v122
    v_mul_f32 v103, v103, v123
    v_cvt_pk_bf16_f32 v40, v100, v101
    v_cvt_pk_bf16_f32 v41, v102, v103
    buffer_store_dwordx4 v[40:43], v9, s[40:43], s5 offen
    s_cmp_lg_u32 s82, 0
    s_cbranch_scc1 L_assist_tail
L_findone:
    s_barrier
    s_add_u32 m0, s68, 114688
    s_add_u32 s53, s59, 262144
    buffer_load_dwordx4 v3, s[28:31], s53 offen nt lds
    s_add_u32 m0, s68, 118784
    s_add_u32 s53, s59, 327680
    buffer_load_dwordx4 v3, s[28:31], s53 offen nt lds
    s_add_u32 m0, s68, 122880
    s_add_u32 s53, s59, 393216
    buffer_load_dwordx4 v3, s[28:31], s53 offen nt lds
    ds_write_b128 v39, v[40:43] offset:8192
    s_branch L_phase2
L_slowfin:
L_pollGs:
    s_xor_b32 s16, s16, s15
    s_add_u32 s56, s5, s16
    s_add_u32 s53, s56, 0
    buffer_load_dwordx4 v[64:67], v9, s[40:43], s53 offen sc1
    s_add_u32 s53, s56, 917504
    buffer_load_dwordx4 v[72:75], v9, s[40:43], s53 offen sc1
    s_add_u32 s53, s56, 1835008
    buffer_load_dwordx4 v[80:83], v9, s[40:43], s53 offen sc1
    s_add_u32 s53, s56, 2752512
    buffer_load_dwordx4 v[88:91], v9, s[40:43], s53 offen sc1
    s_sub_u32 s17, s17, 1
    s_cbranch_scc1 L_pgs_slow
L_pgs_back:
    s_waitcnt vmcnt(0)
    v_perm_b32 v10, v65, v64, s13
    v_perm_b32 v32, v67, v66, s14
    v_perm_b32 v11, v73, v72, s13
    v_perm_b32 v33, v75, v74, s14
    v_or_b32 v10, v10, v32
    v_or_b32 v11, v11, v33
    v_cmp_ne_u64 vcc, v[10:11], v[14:15]
    v_perm_b32 v10, v81, v80, s13
    v_perm_b32 v32, v83, v82, s14
    v_perm_b32 v11, v89, v88, s13
    v_perm_b32 v33, v91, v90, s14
    v_or_b32 v10, v10, v32
    v_or_b32 v11, v11, v33
    v_cmp_ne_u64 s[70:71], v[10:11], v[14:15]
    v_perm_b32 v104, v64, v61, s60
    v_perm_b32 v105, v65, v61, s60
    v_perm_b32 v106, v66, v61, s60
    v_perm_b32 v107, v67, v61, s60
    v_perm_b32 v108, v72, v61, s60
    v_perm_b32 v109, v73, v61, s60
    v_perm_b32 v110, v74, v61, s60
    v_perm_b32 v111, v75, v61, s60
    v_perm_b32 v112, v80, v61, s60
    v_perm_b32 v113, v81, v61, s60
    v_perm_b32 v114, v82, v61, s60
    v_perm_b32 v115, v83, v61, s60
    v_perm_b32 v116, v88, v61, s60
    v_perm_b32 v117, v89, v61, s60
    v_perm_b32 v118, v90, v61, s60
    v_perm_b32 v119, v91, v61, s60
    v_add_f32 v96, v104, v108
    v_add_f32 v97, v105, v109
    v_add_f32 v98, v106, v110
    v_add_f32 v99, v107, v111
    v_add_f32 v112, v112, v116
    v_add_f32 v113, v113, v117
    v_add_f32 v114, v114, v118
    v_add_f32 v115, v115, v119
    v_add_f32 v96, v96, v112
    v_add_f32 v97, v97, v113
    v_add_f32 v98, v98, v114
    v_add_f32 v99, v99, v115
    s_or_b64 vcc, vcc, s[70:71]
    s_cbranch_scc1 L_pollGs
    s_xor_b32 s16, s16, s15
    s_add_u32 s56, s5, s16
    s_add_u32 s53, s56, 458752
    buffer_load_dwordx4 v[68:71], v9, s[40:43], s53 offen sc1
    s_add_u32 s53, s56, 1376256
    buffer_load_dwordx4 v[76:79], v9, s[40:43], s53 offen sc1
    s_add_u32 s53, s56, 2293760
    buffer_load_dwordx4 v[84:87], v9, s[40:43], s53 offen sc1
    s_add_u32 s53, s56, 3211264
    buffer_load_dwordx4 v[92:95], v9, s[40:43], s53 offen sc1
    s_cmp_lg_u32 s82, 0
    s_cbranch_scc1 L_noDs
    s_add_u32 m0, s68, 98304
    s_add_u32 s53, s59, 0
    buffer_load_dwordx4 v3, s[28:31], s53 offen nt lds
    s_add_u32 m0, s68, 102400
    s_add_u32 s53, s59, 65536
    buffer_load_dwordx4 v3, s[28:31], s53 offen nt lds
    s_add_u32 m0, s68, 106496
    s_add_u32 s53, s59, 131072
    buffer_load_dwordx4 v3, s[28:31], s53 offen nt lds
    s_add_u32 m0, s68, 110592
    s_add_u32 s53, s59, 196608
    buffer_load_dwordx4 v3, s[28:31], s53 offen nt lds
L_noDs:
    v_cvt_pk_bf16_f32 v97, v96, v97
    v_cvt_pk_bf16_f32 v99, v98, v99
    v_lshlrev_b32 v96, 16, v97
    v_and_b32 v97, 0xffff0000, v97
    v_lshlrev_b32 v98, 16, v99
    v_and_b32 v99, 0xffff0000, v99
    v_mul_f32 v120, v96, v96
    v_mul_f32 v121, v97, v97
    v_mul_f32 v122, v98, v98
    v_mul_f32 v123, v99, v99
    v_fma_f32 v120, v120, s65, v56
    v_fma_f32 v121, v121, s65, v56
    v_fma_f32 v122, v122, s65, v56
    v_fma_f32 v123, v123, s65, v56
    v_mul_f32 v120, v120, v96
    v_mul_f32 v121, v121, v97
    v_mul_f32 v122, v122, v98
    v_mul_f32 v123, v123, v99
    v_exp_f32 v120, v120
    v_exp_f32 v121, v121
    v_exp_f32 v122, v122
    v_exp_f32 v123, v123
    v_add_f32 v120, 1.0, v120
    v_add_f32 v121, 1.0, v121
    v_add_f32 v122, 1.0, v122
    v_add_f32 v123, 1.0, v123
    v_rcp_f32 v120, v120
    v_rcp_f32 v121, v121
    v_rcp_f32 v122, v122
    v_rcp_f32 v123, v123
    v_mul_f32 v120, v120, v96
    v_mul_f32 v121, v121, v97
    v_mul_f32 v122, v122, v98
    v_mul_f32 v123, v123, v99
    v_cvt_pk_bf16_f32 v121, v120, v121
    v_cvt_pk_bf16_f32 v123, v122, v123
    v_lshlrev_b32 v120, 16, v121
    v_and_b32 v121, 0xffff0000, v121
    v_lshlrev_b32 v122, 16, v123
    v_and_b32 v123, 0xffff0000, v123
    s_cmp_lg_u32 s82, 0
    s_cbranch_scc1 L_wUs
    s_waitcnt vmcnt(4)
    s_branch L_ckUs
L_pollUs:
    s_xor_b32 s16, s16, s15
    s_add_u32 s56, s5, s16
    s_add_u32 s53, s56, 458752
    buffer_load_dwordx4 v[68:71], v9, s[40:43], s53 offen sc1
    s_add_u32 s53, s56, 1376256
    buffer_load_dwordx4 v[76:79], v9, s[40:43], s53 offen sc1
    s_add_u32 s53, s56, 2293760
    buffer_load_dwordx4 v[84:87], v9, s[40:43], s53 offen sc1
    s_add_u32 s53, s56, 3211264
    buffer_load_dwordx4 v[92:95], v9, s[40:43], s53 offen sc1
    s_sub_u32 s17, s17, 1
    s_cbranch_scc1 L_pus_slow
L_pus_back:
L_wUs:
    s_waitcnt vmcnt(0)
L_ckUs:
    v_perm_b32 v10, v69, v68, s13
    v_perm_b32 v32, v71, v70, s14
    v_perm_b32 v11, v77, v76, s13
    v_perm_b32 v33, v79, v78, s14
    v_or_b32 v10, v10, v32
    v_or_b32 v11, v11, v33
    v_cmp_ne_u64 vcc, v[10:11], v[14:15]
    v_perm_b32 v10, v85, v84, s13
    v_perm_b32 v32, v87, v86, s14
    v_perm_b32 v11, v93, v92, s13
    v_perm_b32 v33, v95, v94, s14
    v_or_b32 v10, v10, v32
    v_or_b32 v11, v11, v33
    v_cmp_ne_u64 s[70:71], v[10:11], v[14:15]
    v_perm_b32 v104, v68, v61, s60
    v_perm_b32 v105, v69, v61, s60
    v_perm_b32 v106, v70, v61, s60
    v_perm_b32 v107, v71, v61, s60
    v_perm_b32 v108, v76, v61, s60
    v_perm_b32 v109, v77, v61, s60
    v_perm_b32 v110, v78, v61, s60
    v_perm_b32 v111, v79, v61, s60
    v_perm_b32 v112, v84, v61, s60
    v_perm_b32 v113, v85, v61, s60
    v_perm_b32 v114, v86, v61, s60
    v_perm_b32 v115, v87, v61, s60
    v_perm_b32 v116, v92, v61, s60
    v_perm_b32 v117, v93, v61, s60
    v_perm_b32 v118, v94, v61, s60
    v_perm_b32 v119, v95, v61, s60
    v_add_f32 v100, v104, v108
    v_add_f32 v101, v105, v109
    v_add_f32 v102, v106, v110
    v_add_f32 v103, v107, v111
    v_add_f32 v112, v112, v116
    v_add_f32 v113, v113, v117
    v_add_f32 v114, v114, v118
    v_add_f32 v115, v115, v119
    v_add_f32 v100, v100, v112
    v_add_f32 v101, v101, v113
    v_add_f32 v102, v102, v114
    v_add_f32 v103, v103, v115
    s_or_b64 vcc, vcc, s[70:71]
    s_cbranch_scc1 L_pollUs
    v_cvt_pk_bf16_f32 v101, v100, v101
    v_cvt_pk_bf16_f32 v103, v102, v103
    v_lshlrev_b32 v100, 16, v101
    v_and_b32 v101, 0xffff0000, v101
    v_lshlrev_b32 v102, 16, v103
    v_and_b32 v103, 0xffff0000, v103
    v_mul_f32 v100, v100, v120
    v_mul_f32 v101, v101, v121
    v_mul_f32 v102, v102, v122
    v_mul_f32 v103, v103, v123
    v_cvt_pk_bf16_f32 v40, v100, v101
    v_cvt_pk_bf16_f32 v41, v102, v103
    buffer_store_dwordx4 v[40:43], v9, s[40:43], s5 offen
    s_branch L_findone
L_assist:
    s_barrier
    s_barrier
    s_barrier
    s_barrier
    s_cmp_ge_u32 s48, 6
    s_cbranch_scc1 L_assist_wait
    s_add_u32 s5, s5, 1024
    v_mov_b32 v13, 0
    s_mov_b32 s56, 2560000
L_tau3:
    v_readfirstlane_b32 s52, v13
    s_cmp_lg_u32 s52, 0
    s_cbranch_scc1 L_tau3_ok
    buffer_load_dword v13, v8, s[36:39], 0 offen sc1
    s_sub_u32 s56, s56, 1
    s_cbranch_scc1 L_end
    s_waitcnt vmcnt(0)
    s_branch L_tau3
L_tau3_ok:
    v_alignbit_b32 v12, v13, v13, 16
    v_not_b32 v12, v12
    v_mov_b32 v14, v13
    v_mov_b32 v15, v13
    v_mov_b32 v42, v12
    v_mov_b32 v43, v13
    s_branch L_pollGm
L_assist_tail:
    s_barrier
    ds_write_b128 v39, v[40:43] offset:9216
    s_waitcnt lgkmcnt(0)
    s_branch L_assist_w2
L_assist_wait:
    s_barrier
L_assist_w2:
    s_barrier
    s_barrier
    ds_read_b128 v[224:227], v39 offset:8192
    s_add_u32 s54, s7, 12058624
    s_waitcnt lgkmcnt(0)
    buffer_store_dwordx4 v[224:227], v9, s[40:43], s54 offen sc1
    s_cmp_ge_u32 s48, 6
    s_cbranch_scc1 L_end
    buffer_store_dwordx4 v[40:43], v9, s[40:43], s54 offen offset:1024 sc1
    s_endpgm
L_pc_slow:
    s_call_b64 s[18:19], L_slow
    s_branch L_pc_back
L_rb_slow:
    s_call_b64 s[18:19], L_slow
    s_branch L_rb_back
L_wa_slow:
    s_call_b64 s[18:19], L_slow
    s_branch L_wa_back
L_pgm_slow:
    s_call_b64 s[18:19], L_slow
    s_branch L_pgm_back
L_pum_slow:
    s_call_b64 s[18:19], L_slow
    s_branch L_pum_back
L_pgs_slow:
    s_call_b64 s[18:19], L_slow
    s_branch L_pgs_back
L_pus_slow:
    s_call_b64 s[18:19], L_slow
    s_branch L_pus_back
L_slow:
    s_sub_u32 s64, s64, 1
    s_cbranch_scc1 L_end
    s_mov_b32 s17, 128
    s_mov_b32 s15, 8388608
    s_mov_b32 s66, 12058624
    ds_read_b128 v[224:227], v9 offset:0
    ds_read_b128 v[228:231], v9 offset:1024
    ds_read_b128 v[232:235], v9 offset:2048
    ds_read_b128 v[236:239], v9 offset:3072
    ds_read_b128 v[240:243], v9 offset:4096
    ds_read_b128 v[244:247], v9 offset:5120
    ds_read_b128 v[248:251], v9 offset:6144
    ds_read_b128 v[252:255], v9 offset:7168
    s_lshl_b32 s54, s46, 11
    s_sub_u32 s53, s4, s54
    s_add_u32 s53, s53, 8388608
    s_add_u32 s54, s53, 4096
    s_waitcnt lgkmcnt(0)
    buffer_store_dwordx4 v[224:227], v9, s[40:43], s53 offen offset:0 sc1
    buffer_store_dwordx4 v[228:231], v9, s[40:43], s53 offen offset:1024 sc1
    buffer_store_dwordx4 v[232:235], v9, s[40:43], s53 offen offset:2048 sc1
    buffer_store_dwordx4 v[236:239], v9, s[40:43], s53 offen offset:3072 sc1
    buffer_store_dwordx4 v[240:243], v9, s[40:43], s54 offen offset:0 sc1
    buffer_store_dwordx4 v[244:247], v9, s[40:43], s54 offen offset:1024 sc1
    buffer_store_dwordx4 v[248:251], v9, s[40:43], s54 offen offset:2048 sc1
    buffer_store_dwordx4 v[252:255], v9, s[40:43], s54 offen offset:3072 sc1
    s_waitcnt vmcnt(0)
    s_cmp_lt_u32 s45, 24
    s_cbranch_scc1 L_slow_ret
    ds_read_b128 v[224:227], v9 offset:8192
    ds_read_b128 v[228:231], v9 offset:9216
    ds_read_b128 v[232:235], v9 offset:10240
    ds_read_b128 v[236:239], v9 offset:11264
    ds_read_b128 v[240:243], v9 offset:12288
    ds_read_b128 v[244:247], v9 offset:13312
    ds_read_b128 v[248:251], v9 offset:14336
    ds_read_b128 v[252:255], v9 offset:15360
    s_lshl_b32 s54, s46, 11
    s_sub_u32 s53, s7, s54
    s_add_u32 s53, s53, 12058624
    s_add_u32 s54, s53, 4096
    s_waitcnt lgkmcnt(0)
    buffer_store_dwordx4 v[224:227], v9, s[40:43], s53 offen offset:0 sc1
    buffer_store_dwordx4 v[232:235], v9, s[40:43], s53 offen offset:2048 sc1
    buffer_store_dwordx4 v[240:243], v9, s[40:43], s54 offen offset:0 sc1
    buffer_store_dwordx4 v[248:251], v9, s[40:43], s54 offen offset:2048 sc1
    s_cmp_ge_u32 s48, 6
    s_cbranch_scc1 L_slow_w
    buffer_store_dwordx4 v[228:231], v9, s[40:43], s53 offen offset:1024 sc1
    buffer_store_dwordx4 v[236:239], v9, s[40:43], s53 offen offset:3072 sc1
    buffer_store_dwordx4 v[244:247], v9, s[40:43], s54 offen offset:1024 sc1
    buffer_store_dwordx4 v[252:255], v9, s[40:43], s54 offen offset:3072 sc1
L_slow_w:
    s_waitcnt vmcnt(0)
L_slow_ret:
    s_setpc_b64 s[18:19]
L_codeend:
.section .rodata,"a"
.p2align 6
.amdhsa_kernel standalone__glu_gated_geglu__sampling_kernel
  .amdhsa_next_free_vgpr 256
  .amdhsa_next_free_sgpr 102
  .amdhsa_accum_offset 256
  .amdhsa_group_segment_fixed_size 0
  .amdhsa_kernarg_size 56
  .amdhsa_user_sgpr_count 2
  .amdhsa_user_sgpr_kernarg_segment_ptr 1
  .amdhsa_system_sgpr_workgroup_id_x 1
  .amdhsa_float_denorm_mode_32 3
.end_amdhsa_kernel
```
